```python
import torch

def _softmax(x, axis=-1):
    return torch.softmax(x, dim=axis)
def _gelu(x):
    return torch.nn.functional.gelu(x, approximate="tanh")
def _silu(x):
    return torch.nn.functional.silu(x)
def _sigmoid(x):
    return torch.sigmoid(x)
def _layernorm(x, axis=-1, eps=1e-5):
    m = x.mean(dim=axis, keepdim=True)
    v = x.var(dim=axis, keepdim=True, unbiased=False)
    return (x - m) / torch.sqrt(v + eps)
def _scatter_add(tgt, idx, src, axis=0):
    return tgt.clone().index_add_(axis, idx, src)
def _segment_sum(src, seg, n):
    out = torch.zeros((n,) + src.shape[1:], dtype=src.dtype)
    return out.index_add_(0, seg, src)
def _pad(x, pw):
    flat = tuple(v for pair in reversed(pw) for v in pair)
    return torch.nn.functional.pad(x, flat)

kernel_name = 'gated_mix__sliding_block_cached__glu_gated_reglu__decode'

def setup_inputs():

    _w = (lambda a: (lambda t: t.to(torch.bfloat16) if t.is_floating_point() else t)(torch.as_tensor(a)))
    def _A_setup():
        B, Sq, D = 1, 1, 512
        Hq, Hkv, Sk, Dh = 32, 32, 8192, 128
        assert Hq % Hkv == 0, (Hq, Hkv)
        return {
            "x": _w((lambda *s: torch.randn(*s, dtype=torch.bfloat16) * 0.05)(B, Sq, D)),
            "k_cache": _w((lambda *s: torch.randn(*s, dtype=torch.bfloat16) * 6.4)(B, Hkv, Sk, Dh)),
            "v_cache": _w((lambda *s: torch.randn(*s, dtype=torch.bfloat16) * 0.05)(B, Hkv, Sk, Dh)),
            "wq": _w((lambda *s: torch.randn(*s, dtype=torch.bfloat16) * 6.4)(D, Hq * Dh) * (D ** -0.5)),
            "wo": _w((lambda *s: torch.randn(*s, dtype=torch.bfloat16) * 0.05)(Hq * Dh, D) * ((Hq * Dh) ** -0.5)),
        }
    _A_in = _A_setup()

    def _B_setup():
        B, S, D, F = 1, 1, 512, 1376
        return {
            "x": _w((lambda *s: torch.randn(*s, dtype=torch.bfloat16) * 0.05)(B, S, D)),
            "W_gate": _w((lambda *s: torch.randn(*s, dtype=torch.bfloat16) * 0.8)(D, F) * (2.0 / D) ** 0.5),
            "W_up": _w((lambda *s: torch.randn(*s, dtype=torch.bfloat16) * 0.8)(D, F) * (2.0 / D) ** 0.5),
            "W_down": _w((lambda *s: torch.randn(*s, dtype=torch.bfloat16) * 0.8)(F, D) * (1.0 / F) ** 0.5),
        }
    _B_in = _B_setup()

    return {
        "A_x": _A_in["x"],
        "A_k_cache": _A_in["k_cache"],
        "A_v_cache": _A_in["v_cache"],
        "A_wq": _A_in["wq"],
        "A_wo": _A_in["wo"],
        "B_x": _B_in["x"],
        "B_W_gate": _B_in["W_gate"],
        "B_W_up": _B_in["W_up"],
        "B_W_down": _B_in["W_down"],
        "gate_w": _w((lambda *s: torch.randn(*s, dtype=torch.bfloat16) * 0.1)(512) * 16.0),
    }

def reference(A_x, A_k_cache, A_v_cache, A_wq, A_wo, B_x, B_W_gate, B_W_up, B_W_down, gate_w):
    def _A_ref(x, k_cache, v_cache, wq, wo):
        B, Sq, D = x.shape
        Hq, Dh = 32, 128
        Hkv, Sk = k_cache.shape[1], k_cache.shape[2]
        W = min(4096, max(256, Sk // 4))
        rep = Hq // Hkv
        q = (lambda x, *d: x.permute(*d))((x @ wq).reshape(B, Sq, Hq, Dh), 0, 2, 1, 3)
        k = (lambda x, n, axis: torch.repeat_interleave(x, n, dim=axis))(k_cache[:, :, Sk - W:, :], rep, axis=1)
        v = (lambda x, n, axis: torch.repeat_interleave(x, n, dim=axis))(v_cache[:, :, Sk - W:, :], rep, axis=1)
        scores = torch.einsum("bhqd,bhkd->bhqk", q, k) * (Dh ** -0.5)
        p = _softmax(scores, axis=-1)
        o = torch.einsum("bhqk,bhkd->bhqd", p, v)
        return (lambda x, *d: x.permute(*d))(o, 0, 2, 1, 3).reshape(B, Sq, Hq * Dh) @ wo

    def _B_ref(x, W_gate, W_up, W_down):
        gate = torch.einsum("bsd,df->bsf", x, W_gate)
        up = torch.einsum("bsd,df->bsf", x, W_up)
        gate = gate * (lambda x, dt: x.to(dt))(gate > 0, gate.dtype)
        h = gate * up
        return torch.einsum("bsf,fd->bsd", h, W_down)

    x = A_x
    g = _sigmoid((x * gate_w).sum(-1, keepdims=True))
    a = _A_ref(x, A_k_cache, A_v_cache, A_wq, A_wo)
    b = _B_ref(x, B_W_gate, B_W_up, B_W_down)
    return g * a + (1 - g) * b
```

```asm
; @launch grid=(256,1,1) block=(640,1,1) lds=9728
.amdgcn_target "amdgcn-amd-amdhsa--gfx950"
.text
.p2align 12
.fill 832, 4, 0xbf800000
.globl gated_mix__sliding_block_cached__glu_gated_reglu__decode_kernel
.p2align 8
.type gated_mix__sliding_block_cached__glu_gated_reglu__decode_kernel,@function
gated_mix__sliding_block_cached__glu_gated_reglu__decode_kernel:
    s_load_dwordx16 s[4:19], s[0:1], 0
    s_load_dwordx8 s[20:27], s[0:1], 64
    s_load_dwordx2 s[28:29], s[0:1], 96
    s_cmpk_ge_u32 s2, 256
    s_cbranch_scc1 L_fin
    v_lshrrev_b32 v5, 6, v0
    s_and_b32 s31, s2, 7
    s_lshr_b32 s32, s2, 3
    v_readfirstlane_b32 s38, v5
    s_lshr_b32 s33, s2, 5
    s_and_b32 s40, s32, 3
    s_lshl2_add_u32 s34, s31, s40
    v_and_b32 v1, 63, v0
    v_and_b32 v3, 15, v0
    v_and_b32 v4, 7, v0
    v_lshlrev_b32 v7, 4, v3
    v_lshlrev_b32 v6, 4, v4
    v_lshrrev_b32 v8, 5, v1
    s_lshl_b32 s39, s33, 7
    s_cmp_lt_u32 s38, 2
    s_cbranch_scc1 L_fi
    s_cmp_lg_u32 s38, 2
    s_cbranch_scc1 L_stream
    s_getpc_b64 s[56:57]
    s_and_b32 s56, s56, 0xffffff00
    s_and_b32 s51, s32, 7
    s_lshl_b32 s51, s51, 10
    v_lshl_add_u32 v2, v6, 3, s51
    v_min_u32 v2, L_fin-gated_mix__sliding_block_cached__glu_gated_reglu__decode_kernel, v2
    global_load_dword v16, v2, s[56:57]
    s_branch L_stream
L_fi:
    v_lshrrev_b32 v2, 4, v1
    v_lshl_add_u32 v22, v3, 2, v2
    v_lshl_add_u32 v22, v22, 1, s39
    s_lshl_b32 s51, s31, 2
    s_lshr_b32 s37, 0x45555551, s51
    s_and_b32 s37, s37, 15
    s_mov_b32 s48, 0xe080200
    s_mov_b32 s49, 0x26201a14
    s_lshl_b32 s51, s31, 3
    s_lshr_b64 s[48:49], s[48:49], s51
    s_and_b32 s48, s48, 63
    s_mul_i32 s36, s40, s37
    s_add_u32 s36, s36, s40
    s_lshl2_add_u32 s36, s48, s36
    s_lshl_b32 s48, s34, 4
    s_cmp_eq_u32 s38, 0
    s_movk_i32 s47, 2752
    s_cmovk_i32 s47, 0x2000
    s_cselect_b32 s48, s48, s36
    s_cselect_b32 s49, 15, s37
    s_cselect_b32 s50, 15, 7
    v_and_b32 v5, s50, v3
    v_min_u32 v5, s49, v5
    v_add_lshl_u32 v5, v5, s48, 4
    s_lshl_b32 s51, s33, 6
    v_add_u32 v2, s51, v2
    v_mad_u32_u24 v52, v2, s47, v5
    v_mov_b32 v53, 0
    v_cmp_lt_u32 vcc, 7, v3
    s_lshl_b32 s54, s47, 2
    s_mov_b32 s55, 0
    s_xor_b32 s61, s34, 0
    s_or_b32 s61, s61, s38
    s_cbranch_scc1 L_noclr
    s_lshl_b32 s51, s33, 11
    s_add_u32 s51, s51, 0xc2000
    v_lshrrev_b32 v60, 2, v0
    v_lshl_add_u32 v60, v60, 7, s51
    v_and_b32 v61, 48, v7
    v_add_u32 v60, v60, v61
    v_mov_b32 v64, 0
    v_mov_b32 v65, 0
    v_mov_b32 v66, 0
    v_mov_b32 v67, 0
    s_waitcnt lgkmcnt(0)
    global_store_dwordx4 v60, v[64:67], s[28:29] sc1
L_noclr:
    s_cmp_eq_u32 s38, 0
    s_waitcnt lgkmcnt(0)
    s_cselect_b64 s[16:17], s[10:11], s[16:17]
    s_cselect_b64 s[18:19], s[10:11], s[18:19]
    global_load_ushort v23, v22, s[4:5]
    v_lshl_add_u64 v[20:21], v[52:53], 0, s[16:17]
    v_lshl_add_u64 v[52:53], v[52:53], 0, s[18:19]
    global_load_ushort v24, v22, s[22:23]
    v_cndmask_b32 v20, v20, v52, vcc
    v_cndmask_b32 v21, v21, v53, vcc
    s_load_dword s30, s[28:29], 0
    s_cbranch_scc1 L_qi
    global_load_dwordx4 v[76:79], v[20:21], off
    v_lshl_add_u64 v[20:21], v[20:21], 0, s[54:55]
    global_load_dwordx4 v[80:83], v[20:21], off
    v_lshl_add_u64 v[20:21], v[20:21], 0, s[54:55]
    global_load_dwordx4 v[84:87], v[20:21], off
    v_lshl_add_u64 v[20:21], v[20:21], 0, s[54:55]
    global_load_dwordx4 v[88:91], v[20:21], off
    v_lshl_add_u64 v[20:21], v[20:21], 0, s[54:55]
    global_load_dwordx4 v[92:95], v[20:21], off
    v_lshl_add_u64 v[20:21], v[20:21], 0, s[54:55]
    global_load_dwordx4 v[96:99], v[20:21], off
    v_lshl_add_u64 v[20:21], v[20:21], 0, s[54:55]
    global_load_dwordx4 v[100:103], v[20:21], off
    v_lshl_add_u64 v[20:21], v[20:21], 0, s[54:55]
    global_load_dwordx4 v[104:107], v[20:21], off
    v_lshl_add_u64 v[20:21], v[20:21], 0, s[54:55]
    global_load_dwordx4 v[108:111], v[20:21], off
    v_lshl_add_u64 v[20:21], v[20:21], 0, s[54:55]
    global_load_dwordx4 v[112:115], v[20:21], off
    v_lshl_add_u64 v[20:21], v[20:21], 0, s[54:55]
    global_load_dwordx4 v[116:119], v[20:21], off
    v_lshl_add_u64 v[20:21], v[20:21], 0, s[54:55]
    global_load_dwordx4 v[120:123], v[20:21], off
    v_lshl_add_u64 v[20:21], v[20:21], 0, s[54:55]
    global_load_dwordx4 v[124:127], v[20:21], off
    v_lshl_add_u64 v[20:21], v[20:21], 0, s[54:55]
    global_load_dwordx4 v[128:131], v[20:21], off
    v_lshl_add_u64 v[20:21], v[20:21], 0, s[54:55]
    global_load_dwordx4 v[132:135], v[20:21], off
    v_lshl_add_u64 v[20:21], v[20:21], 0, s[54:55]
    global_load_dwordx4 v[136:139], v[20:21], off
    s_branch L_qd
L_qi:
    global_load_dwordx4 v[76:79], v[20:21], off nt
    v_lshl_add_u64 v[20:21], v[20:21], 0, s[54:55]
    global_load_dwordx4 v[80:83], v[20:21], off nt
    v_lshl_add_u64 v[20:21], v[20:21], 0, s[54:55]
    global_load_dwordx4 v[84:87], v[20:21], off nt
    v_lshl_add_u64 v[20:21], v[20:21], 0, s[54:55]
    global_load_dwordx4 v[88:91], v[20:21], off nt
    v_lshl_add_u64 v[20:21], v[20:21], 0, s[54:55]
    global_load_dwordx4 v[92:95], v[20:21], off nt
    v_lshl_add_u64 v[20:21], v[20:21], 0, s[54:55]
    global_load_dwordx4 v[96:99], v[20:21], off nt
    v_lshl_add_u64 v[20:21], v[20:21], 0, s[54:55]
    global_load_dwordx4 v[100:103], v[20:21], off nt
    v_lshl_add_u64 v[20:21], v[20:21], 0, s[54:55]
    global_load_dwordx4 v[104:107], v[20:21], off nt
    v_lshl_add_u64 v[20:21], v[20:21], 0, s[54:55]
    global_load_dwordx4 v[108:111], v[20:21], off nt
    v_lshl_add_u64 v[20:21], v[20:21], 0, s[54:55]
    global_load_dwordx4 v[112:115], v[20:21], off nt
    v_lshl_add_u64 v[20:21], v[20:21], 0, s[54:55]
    global_load_dwordx4 v[116:119], v[20:21], off nt
    v_lshl_add_u64 v[20:21], v[20:21], 0, s[54:55]
    global_load_dwordx4 v[120:123], v[20:21], off nt
    v_lshl_add_u64 v[20:21], v[20:21], 0, s[54:55]
    global_load_dwordx4 v[124:127], v[20:21], off nt
    v_lshl_add_u64 v[20:21], v[20:21], 0, s[54:55]
    global_load_dwordx4 v[128:131], v[20:21], off nt
    v_lshl_add_u64 v[20:21], v[20:21], 0, s[54:55]
    global_load_dwordx4 v[132:135], v[20:21], off nt
    v_lshl_add_u64 v[20:21], v[20:21], 0, s[54:55]
    global_load_dwordx4 v[136:139], v[20:21], off nt
L_qd:
    s_barrier
    s_getreg_b32 s60, hwreg(HW_REG_XCC_ID, 0, 4)
    s_lshl_b32 s60, s60, 25
    s_add_u32 s60, s60, 0x20000000
    s_mov_b32 s42, 0x0c0c0400
    s_mov_b32 s43, 400000
    s_mov_b32 s44, 0xffff0000
    s_movk_i32 s3, 0xff00
    v_lshlrev_b32 v2, 4, v0
    v_mov_b32 v3, 0xffff
    v_lshlrev_b32 v2, v2, v3
    v_bfe_u32 v3, v0, 1, 2
    v_cmp_eq_u32 vcc, 0, v3
    v_mov_b32 v38, 0
    v_mov_b32 v39, 0
    v_cndmask_b32 v28, 0, v2, vcc
    v_cmp_eq_u32 vcc, 1, v3
    v_mov_b32 v40, 0
    v_mov_b32 v41, 0
    v_cndmask_b32 v29, 0, v2, vcc
    v_cmp_eq_u32 vcc, 2, v3
    v_mov_b32 v42, 0
    v_mov_b32 v43, 0
    v_cndmask_b32 v30, 0, v2, vcc
    v_cmp_eq_u32 vcc, 3, v3
    v_mov_b32 v44, 0
    v_mov_b32 v45, 0
    v_cndmask_b32 v31, 0, v2, vcc
    s_lshl_b32 s51, s34, 4
    s_add_u32 s51, s51, s38
    s_lshl_b32 s51, s51, 9
    s_add_u32 s51, s51, 0x2000
    v_and_b32 v3, 31, v0
    v_lshl_add_u32 v10, v3, 4, s51
    v_lshl_add_u32 v26, v8, 10, v10
    v_add_u32 v26, 0x1000, v26
    s_lshl_b32 s51, s33, 10
    v_add_u32 v10, s51, v10
    s_lshl_b32 s51, s33, 2
    v_mov_b32 v27, s51
    v_bfe_u32 v4, v0, 4, 1
    v_lshl_add_u32 v5, v4, 1, v8
    s_lshl_b32 s51, s38, 8
    v_lshl_add_u32 v32, v5, 2, s51
    v_add_u32 v32, v7, v32
    v_lshlrev_b32 v35, 3, v5
    v_lshl_add_u32 v35, v6, 1, v35
    v_lshrrev_b32 v5, 3, v1
    s_lshl_b32 s51, s36, 13
    s_add_u32 s51, s51, s39
    v_lshl_add_u32 v9, v5, 10, v6
    v_add_u32 v9, s51, v9
    v_lshl_add_u32 v34, v5, 1, v6
    s_add_u32 s56, s28, 0x80000
    s_addc_u32 s57, s29, 0
    s_mov_b64 s[62:63], s[28:29]
    s_lshl_b32 s58, s38, 7
    s_mov_b32 s59, 0
    s_barrier
    s_barrier
    s_waitcnt vmcnt(16)
    v_lshlrev_b32 v2, 16, v23
    v_lshlrev_b32 v24, 16, v24
    v_or_b32 v23, v2, v23
    v_mul_f32 v25, v2, v24
    v_cvt_pk_bf16_f32 v25, v25, v25
    v_and_b32 v25, s44, v25
    v_and_b32_dpp v60, v23, v28 row_newbcast:0 row_mask:0xf bank_mask:0xf
    v_and_b32_dpp v61, v23, v29 row_newbcast:0 row_mask:0xf bank_mask:0xf
    v_and_b32_dpp v62, v23, v30 row_newbcast:0 row_mask:0xf bank_mask:0xf
    v_and_b32_dpp v63, v23, v31 row_newbcast:0 row_mask:0xf bank_mask:0xf
    v_add_f32_dpp v25, v25, v25 quad_perm:[1,0,3,2] row_mask:0xf bank_mask:0xf
    s_waitcnt vmcnt(15)
    v_mfma_f32_16x16x32_bf16 v[56:59], v[60:63], v[76:79], 0
    v_and_b32_dpp v64, v23, v28 row_newbcast:1 row_mask:0xf bank_mask:0xf
    v_and_b32_dpp v65, v23, v29 row_newbcast:1 row_mask:0xf bank_mask:0xf
    v_and_b32_dpp v66, v23, v30 row_newbcast:1 row_mask:0xf bank_mask:0xf
    v_and_b32_dpp v67, v23, v31 row_newbcast:1 row_mask:0xf bank_mask:0xf
    v_add_f32_dpp v25, v25, v25 quad_perm:[2,3,0,1] row_mask:0xf bank_mask:0xf
    s_waitcnt vmcnt(14)
    v_mfma_f32_16x16x32_bf16 v[56:59], v[64:67], v[80:83], v[56:59]
    v_and_b32_dpp v60, v23, v28 row_newbcast:2 row_mask:0xf bank_mask:0xf
    v_and_b32_dpp v61, v23, v29 row_newbcast:2 row_mask:0xf bank_mask:0xf
    v_and_b32_dpp v62, v23, v30 row_newbcast:2 row_mask:0xf bank_mask:0xf
    v_and_b32_dpp v63, v23, v31 row_newbcast:2 row_mask:0xf bank_mask:0xf
    v_add_f32_dpp v25, v25, v25 row_ror:4 row_mask:0xf bank_mask:0xf
    s_waitcnt vmcnt(13)
    v_mfma_f32_16x16x32_bf16 v[56:59], v[60:63], v[84:87], v[56:59]
    v_and_b32_dpp v64, v23, v28 row_newbcast:3 row_mask:0xf bank_mask:0xf
    v_and_b32_dpp v65, v23, v29 row_newbcast:3 row_mask:0xf bank_mask:0xf
    v_and_b32_dpp v66, v23, v30 row_newbcast:3 row_mask:0xf bank_mask:0xf
    v_and_b32_dpp v67, v23, v31 row_newbcast:3 row_mask:0xf bank_mask:0xf
    v_add_f32_dpp v25, v25, v25 row_ror:8 row_mask:0xf bank_mask:0xf
    s_waitcnt vmcnt(12)
    v_mfma_f32_16x16x32_bf16 v[56:59], v[64:67], v[88:91], v[56:59]
    v_and_b32_dpp v60, v23, v28 row_newbcast:4 row_mask:0xf bank_mask:0xf
    v_and_b32_dpp v61, v23, v29 row_newbcast:4 row_mask:0xf bank_mask:0xf
    v_and_b32_dpp v62, v23, v30 row_newbcast:4 row_mask:0xf bank_mask:0xf
    v_and_b32_dpp v63, v23, v31 row_newbcast:4 row_mask:0xf bank_mask:0xf
    v_mov_b32 v2, v25
    s_waitcnt vmcnt(11)
    v_mfma_f32_16x16x32_bf16 v[56:59], v[60:63], v[92:95], v[56:59]
    v_and_b32_dpp v64, v23, v28 row_newbcast:5 row_mask:0xf bank_mask:0xf
    v_and_b32_dpp v65, v23, v29 row_newbcast:5 row_mask:0xf bank_mask:0xf
    v_and_b32_dpp v66, v23, v30 row_newbcast:5 row_mask:0xf bank_mask:0xf
    v_and_b32_dpp v67, v23, v31 row_newbcast:5 row_mask:0xf bank_mask:0xf
    v_permlane16_swap_b32 v25, v2
    s_waitcnt vmcnt(10)
    v_mfma_f32_16x16x32_bf16 v[56:59], v[64:67], v[96:99], v[56:59]
    v_and_b32_dpp v60, v23, v28 row_newbcast:6 row_mask:0xf bank_mask:0xf
    v_and_b32_dpp v61, v23, v29 row_newbcast:6 row_mask:0xf bank_mask:0xf
    v_and_b32_dpp v62, v23, v30 row_newbcast:6 row_mask:0xf bank_mask:0xf
    v_and_b32_dpp v63, v23, v31 row_newbcast:6 row_mask:0xf bank_mask:0xf
    v_add_f32 v25, v25, v2
    s_waitcnt vmcnt(9)
    v_mfma_f32_16x16x32_bf16 v[56:59], v[60:63], v[100:103], v[56:59]
    v_and_b32_dpp v64, v23, v28 row_newbcast:7 row_mask:0xf bank_mask:0xf
    v_and_b32_dpp v65, v23, v29 row_newbcast:7 row_mask:0xf bank_mask:0xf
    v_and_b32_dpp v66, v23, v30 row_newbcast:7 row_mask:0xf bank_mask:0xf
    v_and_b32_dpp v67, v23, v31 row_newbcast:7 row_mask:0xf bank_mask:0xf
    v_mov_b32 v2, v25
    s_waitcnt vmcnt(8)
    v_mfma_f32_16x16x32_bf16 v[56:59], v[64:67], v[104:107], v[56:59]
    v_and_b32_dpp v60, v23, v28 row_newbcast:8 row_mask:0xf bank_mask:0xf
    v_and_b32_dpp v61, v23, v29 row_newbcast:8 row_mask:0xf bank_mask:0xf
    v_and_b32_dpp v62, v23, v30 row_newbcast:8 row_mask:0xf bank_mask:0xf
    v_and_b32_dpp v63, v23, v31 row_newbcast:8 row_mask:0xf bank_mask:0xf
    v_permlane32_swap_b32 v25, v2
    s_waitcnt vmcnt(7)
    v_mfma_f32_16x16x32_bf16 v[56:59], v[60:63], v[108:111], v[56:59]
    v_and_b32_dpp v64, v23, v28 row_newbcast:9 row_mask:0xf bank_mask:0xf
    v_and_b32_dpp v65, v23, v29 row_newbcast:9 row_mask:0xf bank_mask:0xf
    v_and_b32_dpp v66, v23, v30 row_newbcast:9 row_mask:0xf bank_mask:0xf
    v_and_b32_dpp v67, v23, v31 row_newbcast:9 row_mask:0xf bank_mask:0xf
    v_add_f32 v25, v25, v2
    s_waitcnt vmcnt(6)
    v_mfma_f32_16x16x32_bf16 v[56:59], v[64:67], v[112:115], v[56:59]
    v_and_b32_dpp v60, v23, v28 row_newbcast:10 row_mask:0xf bank_mask:0xf
    v_and_b32_dpp v61, v23, v29 row_newbcast:10 row_mask:0xf bank_mask:0xf
    v_and_b32_dpp v62, v23, v30 row_newbcast:10 row_mask:0xf bank_mask:0xf
    v_and_b32_dpp v63, v23, v31 row_newbcast:10 row_mask:0xf bank_mask:0xf
    s_waitcnt vmcnt(5)
    s_nop 0
    v_mfma_f32_16x16x32_bf16 v[56:59], v[60:63], v[116:119], v[56:59]
    v_and_b32_dpp v64, v23, v28 row_newbcast:11 row_mask:0xf bank_mask:0xf
    v_and_b32_dpp v65, v23, v29 row_newbcast:11 row_mask:0xf bank_mask:0xf
    v_and_b32_dpp v66, v23, v30 row_newbcast:11 row_mask:0xf bank_mask:0xf
    v_and_b32_dpp v67, v23, v31 row_newbcast:11 row_mask:0xf bank_mask:0xf
    s_waitcnt vmcnt(4)
    s_nop 0
    v_mfma_f32_16x16x32_bf16 v[56:59], v[64:67], v[120:123], v[56:59]
    v_and_b32_dpp v60, v23, v28 row_newbcast:12 row_mask:0xf bank_mask:0xf
    v_and_b32_dpp v61, v23, v29 row_newbcast:12 row_mask:0xf bank_mask:0xf
    v_and_b32_dpp v62, v23, v30 row_newbcast:12 row_mask:0xf bank_mask:0xf
    v_and_b32_dpp v63, v23, v31 row_newbcast:12 row_mask:0xf bank_mask:0xf
    s_waitcnt vmcnt(3)
    s_nop 0
    v_mfma_f32_16x16x32_bf16 v[56:59], v[60:63], v[124:127], v[56:59]
    v_and_b32_dpp v64, v23, v28 row_newbcast:13 row_mask:0xf bank_mask:0xf
    v_and_b32_dpp v65, v23, v29 row_newbcast:13 row_mask:0xf bank_mask:0xf
    v_and_b32_dpp v66, v23, v30 row_newbcast:13 row_mask:0xf bank_mask:0xf
    v_and_b32_dpp v67, v23, v31 row_newbcast:13 row_mask:0xf bank_mask:0xf
    s_waitcnt vmcnt(2)
    s_nop 0
    v_mfma_f32_16x16x32_bf16 v[56:59], v[64:67], v[128:131], v[56:59]
    v_and_b32_dpp v60, v23, v28 row_newbcast:14 row_mask:0xf bank_mask:0xf
    v_and_b32_dpp v61, v23, v29 row_newbcast:14 row_mask:0xf bank_mask:0xf
    v_and_b32_dpp v62, v23, v30 row_newbcast:14 row_mask:0xf bank_mask:0xf
    v_and_b32_dpp v63, v23, v31 row_newbcast:14 row_mask:0xf bank_mask:0xf
    s_waitcnt vmcnt(1)
    s_nop 0
    v_mfma_f32_16x16x32_bf16 v[56:59], v[60:63], v[132:135], v[56:59]
    v_and_b32_dpp v64, v23, v28 row_newbcast:15 row_mask:0xf bank_mask:0xf
    v_and_b32_dpp v65, v23, v29 row_newbcast:15 row_mask:0xf bank_mask:0xf
    v_and_b32_dpp v66, v23, v30 row_newbcast:15 row_mask:0xf bank_mask:0xf
    v_and_b32_dpp v67, v23, v31 row_newbcast:15 row_mask:0xf bank_mask:0xf
    s_waitcnt vmcnt(0)
    s_nop 0
    v_mfma_f32_16x16x32_bf16 v[56:59], v[64:67], v[136:139], v[56:59]
    s_waitcnt lgkmcnt(0)
    s_add_u32 s30, s30, 0x01010101
    s_lshr_b32 s52, s60, 1
    s_xor_b32 s52, s52, s30
    s_mov_b32 s53, s52
    s_mov_b64 exec, s[58:59]
    s_nop 1
    v_mov_b32 v56, v25
    v_mov_b32 v57, s60
    s_mov_b32 exec_lo, -1
    v_add_u32 v56, 0x80, v56
    v_add_u32 v57, 0x80, v57
    v_add_u32 v58, 0x80, v58
    v_add_u32 v59, 0x80, v59
    v_mov_b32_sdwa v56, s52 dst_sel:BYTE_0 dst_unused:UNUSED_PRESERVE src0_sel:BYTE_0
    v_mov_b32_sdwa v57, s52 dst_sel:BYTE_0 dst_unused:UNUSED_PRESERVE src0_sel:BYTE_1
    v_mov_b32_sdwa v58, s52 dst_sel:BYTE_0 dst_unused:UNUSED_PRESERVE src0_sel:BYTE_2
    v_mov_b32_sdwa v59, s52 dst_sel:BYTE_0 dst_unused:UNUSED_PRESERVE src0_sel:BYTE_3
    s_nop 0
    global_store_dwordx4 v10, v[56:59], s[28:29]
    s_mov_b64 exec, -1
    s_cmp_lg_u32 s61, 0
    s_cbranch_scc1 L_pollA
    s_cmp_lg_u32 s33, 0
    s_cbranch_scc1 L_pollA
    s_sub_u32 s51, s30, 0x01010101
    v_mov_b32 v5, s51
    v_lshlrev_b32 v4, 2, v0
    s_mov_b64 exec, 0xffff
    global_store_dword v4, v5, s[28:29] sc1
    s_mov_b64 exec, -1
    s_branch L_pollA
L_retryA:
    s_sub_u32 s43, s43, 1
    s_cbranch_scc1 L_fin
    s_cmp_gt_u32 s43, 399996
    s_cbranch_scc1 L_pollA
    v_mov_b32 v52, v56
    v_mov_b32 v53, v57
    v_mov_b32 v54, v58
    v_mov_b32 v55, v59
    v_mov_b32_sdwa v55, s30 dst_sel:BYTE_0 dst_unused:UNUSED_PRESERVE src0_sel:BYTE_3
    s_mov_b32 exec_hi, 0
    global_store_dwordx4 v10, v[52:55], s[56:57] sc1
    s_mov_b64 exec, -1
    s_bitcmp1_b32 s43, 0
    s_cselect_b64 s[62:63], s[56:57], s[28:29]
    s_cselect_b32 s53, s30, s52
L_pollA:
    global_load_dwordx4 v[108:111], v26, s[62:63] offset:-4096 sc1
    global_load_dwordx4 v[112:115], v26, s[62:63] offset:-2048 sc1
    global_load_dwordx4 v[116:119], v26, s[62:63] offset:0 sc1
    global_load_dwordx4 v[120:123], v26, s[62:63] offset:2048 sc1
    s_cmp_lg_u32 s61, 0
    s_waitcnt vmcnt(0)
    s_cbranch_scc1 L_nofl
    s_mov_b64 exec, 1
    global_store_dword v27, v28, s[26:27] sc1
    s_mov_b64 exec, -1
L_nofl:
    v_perm_b32 v2, v109, v108, s42
    v_perm_b32 v3, v111, v110, s42
    v_lshl_or_b32 v2, v3, 16, v2
    v_cmp_ne_u32 s[4:5], s53, v2
    v_perm_b32 v2, v113, v112, s42
    v_perm_b32 v3, v115, v114, s42
    v_lshl_or_b32 v2, v3, 16, v2
    v_cmp_ne_u32 s[6:7], s53, v2
    v_perm_b32 v2, v117, v116, s42
    v_perm_b32 v3, v119, v118, s42
    v_lshl_or_b32 v2, v3, 16, v2
    v_cmp_ne_u32 s[8:9], s53, v2
    v_perm_b32 v2, v121, v120, s42
    v_perm_b32 v3, v123, v122, s42
    v_lshl_or_b32 v2, v3, 16, v2
    v_cmp_ne_u32 s[10:11], s53, v2
    s_or_b64 s[4:5], s[4:5], s[6:7]
    s_or_b64 s[8:9], s[8:9], s[10:11]
    s_or_b64 s[4:5], s[4:5], s[8:9]
    s_cbranch_scc1 L_retryA
    v_and_b32 v108, s3, v108
    v_and_b32 v109, s3, v109
    v_and_b32 v110, s3, v110
    v_and_b32 v111, s3, v111
    v_and_b32 v112, s3, v112
    v_and_b32 v113, s3, v113
    v_and_b32 v114, s3, v114
    v_and_b32 v115, s3, v115
    v_and_b32 v116, s3, v116
    v_and_b32 v117, s3, v117
    v_and_b32 v118, s3, v118
    v_and_b32 v119, s3, v119
    v_and_b32 v120, s3, v120
    v_and_b32 v121, s3, v121
    v_and_b32 v122, s3, v122
    v_and_b32 v123, s3, v123
    v_add_f32 v108, v108, v112
    v_add_f32 v109, v109, v113
    v_add_f32 v110, v110, v114
    v_add_f32 v111, v111, v115
    v_add_f32 v116, v116, v120
    v_add_f32 v117, v117, v121
    v_add_f32 v118, v118, v122
    v_add_f32 v119, v119, v123
    v_add_f32 v108, v108, v116
    v_add_f32 v109, v109, v117
    v_add_f32 v110, v110, v118
    v_add_f32 v111, v111, v119
    s_nop 0
    v_permlane32_swap_b32 v108, v110
    v_permlane32_swap_b32 v109, v111
    v_add_f32 v108, v108, v110
    v_add_f32 v109, v109, v111
    v_cvt_pk_bf16_f32 v108, v108, v109
    ds_write_b32 v32, v108 offset:0
    s_cmp_eq_u32 s38, 0
    s_waitcnt lgkmcnt(0)
    s_barrier
    s_cbranch_scc1 L_q
    ds_read_u16 v2, v34 offset:256
    ds_read_u16 v3, v34 offset:384
    v_and_b32 v4, 7, v0
    v_cmp_ge_u32 vcc, s37, v4
    s_waitcnt lgkmcnt(0)
    v_lshlrev_b32 v2, 16, v2
    v_lshlrev_b32 v3, 16, v3
    v_max_f32 v2, 0, v2
    v_mul_f32 v2, v2, v3
    v_cvt_pk_bf16_f32 v2, v2, v2
    v_cndmask_b32 v2, 0, v2, vcc
    s_nop 1
    v_mov_b32_dpp v38, v2 row_newbcast:0 row_mask:0xf bank_mask:0x3
    v_mov_b32_dpp v39, v2 row_newbcast:1 row_mask:0xf bank_mask:0x3
    v_mov_b32_dpp v40, v2 row_newbcast:2 row_mask:0xf bank_mask:0x3
    v_mov_b32_dpp v41, v2 row_newbcast:3 row_mask:0xf bank_mask:0x3
    v_mov_b32_dpp v42, v2 row_newbcast:4 row_mask:0xf bank_mask:0x3
    v_mov_b32_dpp v43, v2 row_newbcast:5 row_mask:0xf bank_mask:0x3
    v_mov_b32_dpp v38, v2 row_newbcast:8 row_mask:0xf bank_mask:0xc
    v_mov_b32_dpp v39, v2 row_newbcast:9 row_mask:0xf bank_mask:0xc
    v_mov_b32_dpp v40, v2 row_newbcast:10 row_mask:0xf bank_mask:0xc
    v_mov_b32_dpp v41, v2 row_newbcast:11 row_mask:0xf bank_mask:0xc
    v_mov_b32_dpp v42, v2 row_newbcast:12 row_mask:0xf bank_mask:0xc
    v_mov_b32_dpp v43, v2 row_newbcast:13 row_mask:0xf bank_mask:0xc
    s_barrier
    v_and_b32 v108, v38, v28
    v_and_b32 v109, v38, v29
    v_and_b32 v110, v38, v30
    v_and_b32 v111, v38, v31
    v_and_b32 v112, v39, v28
    v_and_b32 v113, v39, v29
    v_and_b32 v114, v39, v30
    v_and_b32 v115, v39, v31
    v_and_b32 v116, v40, v28
    v_and_b32 v117, v40, v29
    v_and_b32 v118, v40, v30
    v_and_b32 v119, v40, v31
    v_and_b32 v120, v41, v28
    v_and_b32 v121, v41, v29
    v_and_b32 v122, v41, v30
    v_and_b32 v123, v41, v31
    v_and_b32 v124, v42, v28
    v_and_b32 v125, v42, v29
    v_and_b32 v126, v42, v30
    v_and_b32 v127, v42, v31
    v_and_b32 v128, v43, v28
    v_and_b32 v129, v43, v29
    v_and_b32 v130, v43, v30
    v_and_b32 v131, v43, v31
    global_load_dword v16, v27, s[26:27] sc1
    global_load_dwordx4 v[76:79], v9, s[20:21] nt
    v_add_u32 v9, 0x2000, v9
    global_load_dwordx4 v[80:83], v9, s[20:21] nt
    v_add_u32 v9, 0x2000, v9
    s_cmp_lt_u32 s37, 2
    s_cbranch_scc1 L_wd
    global_load_dwordx4 v[84:87], v9, s[20:21] nt
    v_add_u32 v9, 0x2000, v9
    s_cmp_lt_u32 s37, 3
    s_cbranch_scc1 L_wd
    global_load_dwordx4 v[88:91], v9, s[20:21] nt
    v_add_u32 v9, 0x2000, v9
    s_cmp_lt_u32 s37, 4
    s_cbranch_scc1 L_wd
    global_load_dwordx4 v[92:95], v9, s[20:21] nt
    v_add_u32 v9, 0x2000, v9
    s_cmp_lt_u32 s37, 5
    s_cbranch_scc1 L_wd
    global_load_dwordx4 v[96:99], v9, s[20:21] nt
L_wd:
    s_barrier
    s_waitcnt vmcnt(0)
    v_mfma_f32_16x16x32_bf16 v[52:55], v[108:111], v[76:79], 0
    v_mfma_f32_16x16x32_bf16 v[52:55], v[112:115], v[80:83], v[52:55]
    v_mfma_f32_16x16x32_bf16 v[52:55], v[116:119], v[84:87], v[52:55]
    v_mfma_f32_16x16x32_bf16 v[52:55], v[120:123], v[88:91], v[52:55]
    v_mfma_f32_16x16x32_bf16 v[52:55], v[124:127], v[92:95], v[52:55]
    v_mfma_f32_16x16x32_bf16 v[52:55], v[128:131], v[96:99], v[52:55]
    s_mov_b32 s54, 0x00ff00ff
    s_mov_b32 s55, s54
    s_nop 5
    v_permlane32_swap_b32 v52, v54
    v_permlane32_swap_b32 v53, v55
    s_nop 0
    v_add_f32_dpp v52, v54, v52 row_ror:8 row_mask:0xf bank_mask:0xf
    v_add_f32_dpp v53, v55, v53 row_ror:8 row_mask:0xf bank_mask:0xf
    s_mov_b64 exec, s[54:55]
    ds_write_b64 v35, v[52:53] offset:9472
    s_mov_b64 exec, -1
L_flag:
    v_cmp_eq_u32 vcc, 0, v16
    s_cbranch_vccz L_f4
    s_sub_u32 s43, s43, 1
    s_cbranch_scc1 L_fin
    global_load_dword v16, v27, s[26:27] sc1
    s_waitcnt vmcnt(0)
    s_branch L_flag
L_q:
    s_barrier
    s_barrier
L_f4:
    s_waitcnt lgkmcnt(0)
    s_barrier
    s_endpgm
    .p2align 12
L_stream:
    s_sub_u32 s38, s38, 2
    v_subrev_u32 v0, 0x80, v0
    s_mov_b32 s48, 0x7c483400
    s_mov_b32 s49, 0xccf884b0
    s_lshl_b32 s51, s38, 3
    s_lshr_b64 s[48:49], s[48:49], s51
    s_mov_b32 s52, 0xc080400
    s_mov_b32 s53, 0x5c585450
    s_lshl_b32 s51, s34, 3
    s_lshr_b64 s[52:53], s[52:53], s51
    s_xor_b32 s48, s48, s52
    s_and_b32 s48, s48, 0xff
    s_lshl2_add_u32 s40, s34, 3
    s_lshl3_add_u32 s40, s40, s33
    s_lshl_b32 s40, s40, 8
    s_or_b32 s40, s40, s48
    s_lshl_b32 s40, s40, 8
    v_lshl_add_u32 v20, v1, 4, s40
    v_xor_b32 v21, 0x400, v20
    v_xor_b32 v22, 0x15000, v20
    v_xor_b32 v23, 0x15400, v20
    v_xor_b32 v24, 0x800, v20
    v_xor_b32 v25, 0xc00, v20
    v_xor_b32 v26, 0x15800, v20
    v_xor_b32 v27, 0x15c00, v20
    s_waitcnt lgkmcnt(0)
    s_load_dword s30, s[28:29], 0
    s_barrier
    global_load_dwordx4 v[76:79], v20, s[6:7] nt
    s_barrier
    global_load_dwordx4 v[80:83], v21, s[6:7] nt
    s_barrier
    global_load_dwordx4 v[84:87], v22, s[6:7] nt
    s_cmp_lg_u32 s38, 1
    s_cbranch_scc1 L_notouch
    s_lshl_b32 s51, s34, 17
    s_load_dword s49, s[8:9], s40
    s_load_dword s50, s[12:13], s51
    s_load_dword s35, s[20:21], 0
L_notouch:
    s_getreg_b32 s60, hwreg(HW_REG_XCC_ID, 0, 4)
    s_lshl_b32 s60, s60, 25
    s_add_u32 s60, s60, 0x20000000
    s_mov_b32 s42, 0x0c0c0400
    s_mov_b32 s43, 400000
    s_mov_b32 s44, 0xffff0000
    s_movk_i32 s3, 0xff00
    v_lshlrev_b32 v2, 4, v0
    v_mov_b32 v3, 0xffff
    v_lshlrev_b32 v2, v2, v3
    v_bfe_u32 v3, v0, 1, 2
    v_cmp_eq_u32 vcc, 0, v3
    v_mov_b32 v38, 0
    v_mov_b32 v39, 0
    v_cndmask_b32 v28, 0, v2, vcc
    v_cmp_eq_u32 vcc, 1, v3
    v_mov_b32 v40, 0
    v_mov_b32 v41, 0
    v_cndmask_b32 v29, 0, v2, vcc
    v_cmp_eq_u32 vcc, 2, v3
    v_mov_b32 v42, 0
    v_mov_b32 v43, 0
    v_cndmask_b32 v30, 0, v2, vcc
    v_cmp_eq_u32 vcc, 3, v3
    v_mov_b32 v44, 0
    v_mov_b32 v45, 0
    v_cndmask_b32 v31, 0, v2, vcc
    s_movk_i32 s41, 0xff
    s_mov_b32 s45, 0x3fb8aa3b
    s_mov_b32 s46, 0x3db504f3
    s_mov_b32 s47, 0x403f0000
    s_mov_b32 s52, 0x33333333
    s_mov_b32 s53, s52
    s_mov_b32 s54, 0x00ff00ff
    s_not_b32 s55, s54
    s_mov_b32 s58, 0xaaaaaaaa
    s_mov_b32 s59, s58
    s_mov_b32 s62, s54
    s_mov_b32 s63, s54
    v_mov_b32 v17, s44
    v_lshrrev_b32 v32, 4, v0
    v_lshlrev_b32 v32, 3, v32
    s_lshl3_add_u32 s40, s34, s38
    s_lshl_b32 s40, s40, 14
    s_add_u32 s40, s40, s39
    s_add_u32 s40, s40, 0x1000
    v_and_b32 v3, 8, v0
    v_lshrrev_b32 v4, 4, v1
    v_add_lshl_u32 v9, v3, v4, 10
    v_add3_u32 v9, v9, v6, s40
    s_lshl_b32 s51, s34, 6
    s_add_u32 s51, s51, s38
    s_lshl_b32 s51, s51, 7
    s_add_u32 s51, s51, 0x42000
    v_lshrrev_b32 v3, 3, v1
    v_lshl_add_u32 v11, v3, 10, s51
    v_add_u32 v11, v6, v11
    s_lshl3_add_u32 s51, s39, s51
    v_and_b32 v4, 60, v0
    v_and_b32 v5, 1, v0
    v_lshl_add_u32 v10, v5, 6, s51
    v_add_u32 v10, v4, v10
    v_lshlrev_b32 v14, 1, v4
    v_and_b32 v3, 62, v0
    s_lshl_b32 s51, s38, 7
    v_lshl_add_u32 v37, v3, 1, s51
    v_mul_u32_u24 v36, 2112, v5
    v_add_u32 v36, v37, v36
    s_lshl_b32 s56, s38, 6
    s_add_u32 s51, s56, s39
    v_add_u32 v13, s51, v3
    s_lshl1_add_u32 s51, s33, s38
    s_lshl_b32 s51, s51, 10
    s_add_u32 s51, s51, 0xc2000
    v_lshrrev_b32 v3, 3, v1
    v_lshl_add_u32 v12, v3, 7, s51
    v_lshrrev_b32 v3, 1, v6
    v_add_u32 v12, v3, v12
    v_and_b32 v5, 3, v0
    v_mul_u32_u24 v34, 1056, v5
    v_add3_u32 v34, v34, v4, s56
    s_lshr_b32 s51, s38, 1
    s_lshl_b32 s56, s38, 9
    s_lshl_b32 s51, s51, 5
    s_add_u32 s51, s51, s56
    v_and_b32 v33, 16, v0
    v_lshl_add_u32 v35, v6, 1, v33
    v_lshl_add_u32 v33, v7, 1, v33
    v_add_u32 v33, s51, v33
    s_lshr_b32 s51, s38, 2
    s_lshl_b32 s51, s51, 6
    s_add_u32 s56, s56, s51
    v_lshl_add_u32 v35, v8, 8, v35
    v_add_u32 v35, s56, v35
    s_waitcnt vmcnt(2)
    global_load_dwordx4 v[88:91], v23, s[6:7] nt
    s_waitcnt vmcnt(2)
    global_load_dwordx4 v[92:95], v24, s[6:7] nt
    s_waitcnt vmcnt(2)
    global_load_dwordx4 v[96:99], v25, s[6:7] nt
    s_waitcnt vmcnt(2)
    global_load_dwordx4 v[100:103], v26, s[6:7] nt
    s_waitcnt vmcnt(2)
    global_load_dwordx4 v[104:107], v27, s[6:7] nt
    s_waitcnt vmcnt(2)
    global_load_dwordx4 v[108:111], v20, s[8:9] nt
    s_waitcnt vmcnt(2)
    global_load_dwordx4 v[112:115], v21, s[8:9] nt
    s_waitcnt vmcnt(2)
    global_load_dwordx4 v[116:119], v22, s[8:9] nt
    s_waitcnt vmcnt(2)
    global_load_dwordx4 v[120:123], v23, s[8:9] nt
    global_load_dwordx4 v[124:127], v24, s[8:9] nt
    s_waitcnt lgkmcnt(0)
    s_add_u32 s30, s30, 0x01010101
    v_lshrrev_b32 v14, v14, s30
    s_barrier
    ds_read_b128 v[48:51], v7 offset:0
    ds_read_b32 v18, v38 offset:368
    s_waitcnt vmcnt(5)
    s_waitcnt lgkmcnt(0)
    v_dot2c_f32_bf16 v38, v76, v48
    v_dot2c_f32_bf16 v39, v80, v48
    v_dot2c_f32_bf16 v40, v84, v48
    v_dot2c_f32_bf16 v41, v88, v48
    v_dot2c_f32_bf16 v42, v92, v48
    v_dot2c_f32_bf16 v43, v96, v48
    v_dot2c_f32_bf16 v44, v100, v48
    v_dot2c_f32_bf16 v45, v104, v48
    v_dot2c_f32_bf16 v38, v77, v49
    v_dot2c_f32_bf16 v39, v81, v49
    v_dot2c_f32_bf16 v40, v85, v49
    v_dot2c_f32_bf16 v41, v89, v49
    v_dot2c_f32_bf16 v42, v93, v49
    v_dot2c_f32_bf16 v43, v97, v49
    v_dot2c_f32_bf16 v44, v101, v49
    v_dot2c_f32_bf16 v45, v105, v49
    v_dot2c_f32_bf16 v38, v78, v50
    v_dot2c_f32_bf16 v39, v82, v50
    v_dot2c_f32_bf16 v40, v86, v50
    v_dot2c_f32_bf16 v41, v90, v50
    v_dot2c_f32_bf16 v42, v94, v50
    v_dot2c_f32_bf16 v43, v98, v50
    v_dot2c_f32_bf16 v44, v102, v50
    v_dot2c_f32_bf16 v45, v106, v50
    v_dot2c_f32_bf16 v38, v79, v51
    v_dot2c_f32_bf16 v39, v83, v51
    v_dot2c_f32_bf16 v40, v87, v51
    v_dot2c_f32_bf16 v41, v91, v51
    v_dot2c_f32_bf16 v42, v95, v51
    v_dot2c_f32_bf16 v43, v99, v51
    v_dot2c_f32_bf16 v44, v103, v51
    v_dot2c_f32_bf16 v45, v107, v51
    global_load_dwordx4 v[128:131], v25, s[8:9] nt
    v_readfirstlane_b32 s61, v18
    s_add_u32 s60, s60, 0x01800000
    v_add_f32_dpp v38, v38, v38 row_ror:8 row_mask:0xf bank_mask:0x3
    v_add_f32_dpp v39, v39, v39 row_ror:8 row_mask:0xf bank_mask:0x3
    v_add_f32_dpp v40, v40, v40 row_ror:8 row_mask:0xf bank_mask:0x3
    v_add_f32_dpp v41, v41, v41 row_ror:8 row_mask:0xf bank_mask:0x3
    v_add_f32_dpp v38, v42, v42 row_ror:8 row_mask:0xf bank_mask:0xc
    v_add_f32_dpp v39, v43, v43 row_ror:8 row_mask:0xf bank_mask:0xc
    v_add_f32_dpp v40, v44, v44 row_ror:8 row_mask:0xf bank_mask:0xc
    v_add_f32_dpp v41, v45, v45 row_ror:8 row_mask:0xf bank_mask:0xc
    v_add_f32_dpp v38, v38, v38 row_half_mirror row_mask:0xf bank_mask:0x5
    v_add_f32_dpp v39, v39, v39 row_half_mirror row_mask:0xf bank_mask:0x5
    v_lshlrev_b32 v18, 16, v18
    v_add_f32_dpp v38, v40, v40 row_half_mirror row_mask:0xf bank_mask:0xa
    v_add_f32_dpp v39, v41, v41 row_half_mirror row_mask:0xf bank_mask:0xa
    v_mul_f32 v18, s45, v18
    v_add_f32_dpp v38, v38, v38 quad_perm:[1,0,3,2] row_mask:0xf bank_mask:0xf
    v_add_f32_dpp v39, v39, v39 quad_perm:[1,0,3,2] row_mask:0xf bank_mask:0xf
    v_exp_f32 v18, -v18
    v_add_f32_dpp v38, v38, v38 quad_perm:[2,3,0,1] row_mask:0xf bank_mask:0xf
    v_add_f32_dpp v39, v39, v39 quad_perm:[2,3,0,1] row_mask:0xf bank_mask:0xf
    v_cvt_pk_bf16_f32 v2, v38, v39
    v_lshlrev_b32 v38, 16, v2
    v_and_b32 v39, s44, v2
    v_mul_f32 v38, s46, v38
    v_mul_f32 v39, s46, v39
    v_cvt_pk_bf16_f32 v2, v38, v39
    v_lshlrev_b32 v38, 16, v2
    v_and_b32 v39, s44, v2
    v_max_f32 v40, v38, v39
    v_add_f32 v18, 1.0, v18
    v_rcp_f32 v18, v18
    v_max_f32_dpp v40, v40, v40 row_ror:4 row_mask:0xf bank_mask:0xf
    v_cvt_pk_bf16_f32 v18, v18, v18
    v_and_b32 v18, s44, v18
    v_max_f32_dpp v40, v40, v40 row_ror:8 row_mask:0xf bank_mask:0xf
    v_sub_f32 v38, v38, v40
    v_sub_f32 v39, v39, v40
    v_mul_f32 v38, s45, v38
    v_mul_f32 v39, s45, v39
    v_exp_f32 v38, v38
    v_exp_f32 v39, v39
    v_sub_f32 v19, 1.0, v18
    v_add_f32 v41, v38, v39
    v_cvt_pk_bf16_f32 v19, v19, v19
    v_and_b32 v19, s44, v19
    v_add_f32_dpp v41, v41, v41 row_ror:4 row_mask:0xf bank_mask:0xf
    s_nop 1
    v_add_f32_dpp v41, v41, v41 row_ror:8 row_mask:0xf bank_mask:0xf
    ds_write_b64 v32, v[40:41] offset:512
    s_waitcnt lgkmcnt(0)
    s_barrier
    ds_read_b128 v[52:55], v7 offset:512
    global_load_dwordx4 v[132:135], v26, s[8:9] nt
    global_load_dwordx4 v[136:139], v27, s[8:9] nt
    s_waitcnt lgkmcnt(0)
    v_max_f32 v2, v52, v54
    s_nop 1
    v_max_f32_dpp v2, v2, v2 quad_perm:[1,0,3,2] row_mask:0xf bank_mask:0xf
    s_nop 1
    v_max_f32_dpp v2, v2, v2 quad_perm:[2,3,0,1] row_mask:0xf bank_mask:0xf
    s_nop 1
    v_max_f32_dpp v2, v2, v2 row_ror:4 row_mask:0xf bank_mask:0xf
    s_nop 1
    v_max_f32_dpp v2, v2, v2 row_ror:8 row_mask:0xf bank_mask:0xf
    v_sub_f32 v40, v40, v2
    v_sub_f32 v52, v52, v2
    v_sub_f32 v54, v54, v2
    v_mul_f32 v40, s45, v40
    v_mul_f32 v52, s45, v52
    v_mul_f32 v54, s45, v54
    v_exp_f32 v40, v40
    v_exp_f32 v52, v52
    v_exp_f32 v54, v54
    v_mul_f32 v38, v38, v40
    v_mul_f32 v39, v39, v40
    v_mul_f32 v3, v52, v53
    v_cvt_pk_bf16_f32 v38, v38, v38
    v_cvt_pk_bf16_f32 v39, v39, v39
    v_fmac_f32 v3, v54, v55
    v_cmp_lt_u32 vcc, 15, v1
    v_and_b32_dpp v76, v38, v28 row_newbcast:0 row_mask:0xf bank_mask:0xf
    v_and_b32_dpp v77, v38, v29 row_newbcast:0 row_mask:0xf bank_mask:0xf
    v_and_b32_dpp v78, v38, v30 row_newbcast:0 row_mask:0xf bank_mask:0xf
    v_and_b32_dpp v79, v38, v31 row_newbcast:0 row_mask:0xf bank_mask:0xf
    v_and_b32_dpp v80, v39, v28 row_newbcast:0 row_mask:0xf bank_mask:0xf
    v_and_b32_dpp v81, v39, v29 row_newbcast:0 row_mask:0xf bank_mask:0xf
    v_and_b32_dpp v82, v39, v30 row_newbcast:0 row_mask:0xf bank_mask:0xf
    v_and_b32_dpp v83, v39, v31 row_newbcast:0 row_mask:0xf bank_mask:0xf
    v_add_f32_dpp v3, v3, v3 quad_perm:[1,0,3,2] row_mask:0xf bank_mask:0xf
    s_waitcnt vmcnt(7)
    v_mfma_f32_16x16x32_bf16 v[56:59], v[76:79], v[108:111], 0
    v_and_b32_dpp v84, v38, v28 row_newbcast:4 row_mask:0xf bank_mask:0xf
    v_and_b32_dpp v85, v38, v29 row_newbcast:4 row_mask:0xf bank_mask:0xf
    v_and_b32_dpp v86, v38, v30 row_newbcast:4 row_mask:0xf bank_mask:0xf
    v_and_b32_dpp v87, v38, v31 row_newbcast:4 row_mask:0xf bank_mask:0xf
    v_add_f32_dpp v3, v3, v3 quad_perm:[2,3,0,1] row_mask:0xf bank_mask:0xf
    s_waitcnt vmcnt(6)
    v_mfma_f32_16x16x32_bf16 v[56:59], v[80:83], v[112:115], v[56:59]
    v_and_b32_dpp v88, v39, v28 row_newbcast:4 row_mask:0xf bank_mask:0xf
    v_and_b32_dpp v89, v39, v29 row_newbcast:4 row_mask:0xf bank_mask:0xf
    v_and_b32_dpp v90, v39, v30 row_newbcast:4 row_mask:0xf bank_mask:0xf
    v_and_b32_dpp v91, v39, v31 row_newbcast:4 row_mask:0xf bank_mask:0xf
    v_add_f32_dpp v3, v3, v3 row_ror:4 row_mask:0xf bank_mask:0xf
    s_waitcnt vmcnt(5)
    v_mfma_f32_16x16x32_bf16 v[56:59], v[84:87], v[116:119], v[56:59]
    v_and_b32_dpp v92, v38, v28 row_newbcast:8 row_mask:0xf bank_mask:0xf
    v_and_b32_dpp v93, v38, v29 row_newbcast:8 row_mask:0xf bank_mask:0xf
    v_and_b32_dpp v94, v38, v30 row_newbcast:8 row_mask:0xf bank_mask:0xf
    v_and_b32_dpp v95, v38, v31 row_newbcast:8 row_mask:0xf bank_mask:0xf
    v_add_f32_dpp v3, v3, v3 row_ror:8 row_mask:0xf bank_mask:0xf
    s_waitcnt vmcnt(4)
    v_mfma_f32_16x16x32_bf16 v[56:59], v[88:91], v[120:123], v[56:59]
    v_and_b32_dpp v96, v39, v28 row_newbcast:8 row_mask:0xf bank_mask:0xf
    v_and_b32_dpp v97, v39, v29 row_newbcast:8 row_mask:0xf bank_mask:0xf
    v_and_b32_dpp v98, v39, v30 row_newbcast:8 row_mask:0xf bank_mask:0xf
    v_and_b32_dpp v99, v39, v31 row_newbcast:8 row_mask:0xf bank_mask:0xf
    v_cndmask_b32 v15, v2, v3, vcc
    s_waitcnt vmcnt(3)
    v_mfma_f32_16x16x32_bf16 v[56:59], v[92:95], v[124:127], v[56:59]
    v_and_b32_dpp v100, v38, v28 row_newbcast:12 row_mask:0xf bank_mask:0xf
    v_and_b32_dpp v101, v38, v29 row_newbcast:12 row_mask:0xf bank_mask:0xf
    v_and_b32_dpp v102, v38, v30 row_newbcast:12 row_mask:0xf bank_mask:0xf
    v_and_b32_dpp v103, v38, v31 row_newbcast:12 row_mask:0xf bank_mask:0xf
    s_waitcnt vmcnt(2)
    v_mfma_f32_16x16x32_bf16 v[56:59], v[96:99], v[128:131], v[56:59]
    v_and_b32_dpp v104, v39, v28 row_newbcast:12 row_mask:0xf bank_mask:0xf
    v_and_b32_dpp v105, v39, v29 row_newbcast:12 row_mask:0xf bank_mask:0xf
    v_and_b32_dpp v106, v39, v30 row_newbcast:12 row_mask:0xf bank_mask:0xf
    v_and_b32_dpp v107, v39, v31 row_newbcast:12 row_mask:0xf bank_mask:0xf
    s_waitcnt vmcnt(1)
    v_mfma_f32_16x16x32_bf16 v[56:59], v[100:103], v[132:135], v[56:59]
    global_load_dwordx4 v[68:71], v9, s[12:13] offset:-4096 nt
    s_waitcnt vmcnt(1)
    v_mfma_f32_16x16x32_bf16 v[56:59], v[104:107], v[136:139], v[56:59]
    global_load_dwordx4 v[72:75], v9, s[12:13] offset:0 nt
    s_mov_b32 exec_hi, 0
    s_and_b32 s61, s61, s44
    s_nop 4
    ds_write_b128 v33, v[56:59] offset:768
    s_mov_b64 exec, -1
    s_cmp_lg_u32 s61, s60
    s_waitcnt lgkmcnt(0)
    s_barrier
    ds_read2st64_b32 v[56:57], v34 offset0:3 offset1:5
    s_waitcnt lgkmcnt(0)
    v_add_f32 v16, v56, v57
    s_nop 1
    v_add_f32_dpp v16, v16, v16 quad_perm:[1,0,3,2] row_mask:0xf bank_mask:0xf
    s_nop 1
    v_add_f32_dpp v16, v16, v16 quad_perm:[2,3,0,1] row_mask:0xf bank_mask:0xf
    v_cndmask_b32 v16, v16, v15, s[58:59]
    v_add_u32 v16, 0x80, v16
    v_bfi_b32 v16, s41, v14, v16
    s_mov_b64 exec, s[52:53]
    s_cbranch_scc1 L_farB
    global_store_dword v10, v16, s[28:29]
L_pollB:
    s_mov_b64 exec, -1
    global_load_dwordx4 v[52:55], v11, s[28:29] sc1
L_waitB:
    s_waitcnt vmcnt(0)
    v_perm_b32 v2, v53, v52, s42
    v_perm_b32 v3, v55, v54, s42
    v_lshl_or_b32 v2, v3, 16, v2
    v_cmp_ne_u32 vcc, s30, v2
    v_and_b32_dpp v5, v52, v17 row_newbcast:12 row_mask:0xf bank_mask:0xf
    s_cbranch_vccnz L_retryB
    v_and_b32_dpp v4, v52, v17 row_newbcast:4 row_mask:0xf bank_mask:0xf
    v_max_f32 v3, v4, v5
    v_max_f32 v2, v4, v5
    v_cndmask_b32 v4, v5, v4, s[62:63]
    v_and_b32 v52, s3, v52
    v_permlane16_swap_b32 v2, v3
    v_max_f32 v5, v2, v3
    v_max_f32 v2, v2, v3
    v_and_b32 v53, s3, v53
    v_and_b32 v54, s3, v54
    v_permlane32_swap_b32 v2, v5
    v_max_f32 v2, v2, v5
    v_sub_f32 v2, v4, v2
    v_mul_f32 v2, s45, v2
    v_exp_f32 v2, v2
    v_and_b32 v55, s3, v55
    v_mul_f32 v52, v2, v52
    v_mul_f32 v54, v2, v54
    v_mul_f32 v53, v2, v53
    v_mul_f32 v55, v2, v55
    v_permlane32_swap_b32 v52, v54
    v_add_f32 v52, v52, v54
    v_permlane32_swap_b32 v53, v55
    v_add_f32 v53, v53, v55
    s_nop 1
    v_permlane16_swap_b32 v52, v53
    v_add_f32 v52, v52, v53
    s_nop 1
    v_add_f32_dpp v52, v52, v52 row_ror:8 row_mask:0xf bank_mask:0xf
    s_nop 1
    v_mov_b32_dpp v54, v52 row_newbcast:0 row_mask:0xf bank_mask:0x3
    v_mov_b32_dpp v55, v52 row_newbcast:1 row_mask:0xf bank_mask:0x3
    v_rcp_f32_dpp v3, v52 row_newbcast:5 row_mask:0xf bank_mask:0xf
    v_mov_b32_dpp v54, v52 row_newbcast:2 row_mask:0xf bank_mask:0xc
    v_mov_b32_dpp v55, v52 row_newbcast:3 row_mask:0xf bank_mask:0xc
    v_mul_f32 v54, v3, v54
    v_mul_f32 v55, v3, v55
    v_cvt_pk_bf16_f32 v54, v54, v54
    v_cvt_pk_bf16_f32 v55, v55, v55
    v_and_b32 v60, v54, v28
    v_and_b32 v61, v54, v29
    v_and_b32 v62, v54, v30
    v_and_b32 v63, v54, v31
    v_and_b32 v64, v55, v28
    v_and_b32 v65, v55, v29
    v_mfma_f32_16x16x32_bf16 v[56:59], v[60:63], v[68:71], 0
    v_and_b32 v66, v55, v30
    v_and_b32 v67, v55, v31
    s_cmp_ge_u32 s38, 2
    s_nop 0
    v_mfma_f32_16x16x32_bf16 v[56:59], v[64:67], v[72:75], v[56:59]
    s_mov_b64 exec, s[54:55]
    s_nop 6
    ds_write_b128 v35, v[56:59] offset:5120
    s_mov_b64 exec, -1
    s_waitcnt lgkmcnt(0)
    s_barrier
    s_cbranch_scc1 L_fin
    ds_read_b32 v48, v37 offset:9472
    ds_read2st64_b32 v[38:39], v36 offset0:20 offset1:21
    ds_read2st64_b32 v[40:41], v36 offset0:22 offset1:23
    ds_read2st64_b32 v[42:43], v36 offset0:24 offset1:25
    ds_read2st64_b32 v[44:45], v36 offset0:26 offset1:27
    s_waitcnt lgkmcnt(3)
    v_add_f32 v38, v38, v39
    s_waitcnt lgkmcnt(2)
    v_add_f32 v40, v40, v41
    v_add_f32 v38, v38, v40
    s_waitcnt lgkmcnt(1)
    v_add_f32 v42, v42, v43
    v_add_f32 v38, v38, v42
    s_waitcnt lgkmcnt(0)
    v_add_f32 v44, v44, v45
    v_add_f32 v38, v38, v44
    v_mul_f32 v48, v19, v48
    s_nop 0
    v_add_f32_dpp v38, v38, v38 quad_perm:[1,0,3,2] row_mask:0xf bank_mask:0xf
    v_fmac_f32 v48, v18, v38
    v_cndmask_b32 v48, v48, 1.0, s[58:59]
    v_cvt_f64_f32 v[60:61], v48
    global_atomic_add_f64 v[62:63], v12, v[60:61], s[28:29] sc0
    s_waitcnt vmcnt(0)
    v_cmp_eq_u32 vcc, s47, v63
    v_add_f64 v[60:61], v[60:61], v[62:63]
    s_and_b64 vcc, vcc, s[58:59]
    v_cvt_f32_f64 v49, v[60:61]
    v_cvt_pk_bf16_f32 v3, v49, v49
    s_lshr_b64 exec, vcc, 1
    s_cbranch_scc0 L_fin
    global_store_short v13, v3, s[24:25]
    v_cmp_eq_u32 vcc, 0, v13
    s_cbranch_vccz L_fin
    s_mov_b64 exec, 0xffff
    v_mov_b32 v4, s30
    v_lshlrev_b32 v5, 2, v0
    global_store_dword v5, v4, s[28:29]
    s_endpgm
L_retryB:
    global_load_dwordx4 v[52:55], v11, s[28:29] sc1
    s_sub_u32 s43, s43, 1
    s_cbranch_scc0 L_waitB
    s_endpgm
L_farB:
    global_store_dword v10, v16, s[28:29] sc1
    s_branch L_pollB
L_fin:
    s_endpgm
.section .rodata,"a"
.p2align 6
.amdhsa_kernel gated_mix__sliding_block_cached__glu_gated_reglu__decode_kernel
  .amdhsa_next_free_vgpr 168
  .amdhsa_next_free_sgpr 64
  .amdhsa_accum_offset 168
  .amdhsa_group_segment_fixed_size 0
  .amdhsa_kernarg_size 104
  .amdhsa_user_sgpr_count 2
  .amdhsa_user_sgpr_kernarg_segment_ptr 1
  .amdhsa_system_sgpr_workgroup_id_x 1
  .amdhsa_float_denorm_mode_32 3
.end_amdhsa_kernel
```
